```python
import torch

def _softmax(x, axis=-1):
    return torch.softmax(x, dim=axis)
def _gelu(x):
    return torch.nn.functional.gelu(x, approximate="tanh")
def _silu(x):
    return torch.nn.functional.silu(x)
def _sigmoid(x):
    return torch.sigmoid(x)
def _layernorm(x, axis=-1, eps=1e-5):
    m = x.mean(dim=axis, keepdim=True)
    v = x.var(dim=axis, keepdim=True, unbiased=False)
    return (x - m) / torch.sqrt(v + eps)
def _scatter_add(tgt, idx, src, axis=0):
    return tgt.clone().index_add_(axis, idx, src)
def _segment_sum(src, seg, n):
    out = torch.zeros((n,) + src.shape[1:], dtype=src.dtype)
    return out.index_add_(0, seg, src)
def _pad(x, pw):
    flat = tuple(v for pair in reversed(pw) for v in pair)
    return torch.nn.functional.pad(x, flat)

kernel_name = 'gated_mix__sliding_block_cached__dense_activation_relu__decode'

def setup_inputs():

    _w = (lambda a: (lambda t: t.to(torch.bfloat16) if t.is_floating_point() else t)(torch.as_tensor(a)))
    def _A_setup():
        B, Sq, D = 4, 1, 448
        Hq, Hkv, Sk, Dh = 16, 8, 8192, 256
        assert Hq % Hkv == 0, (Hq, Hkv)
        return {
            "x": _w((lambda *s: torch.randn(*s, dtype=torch.bfloat16) * 0.05)(B, Sq, D)),
            "k_cache": _w((lambda *s: torch.randn(*s, dtype=torch.bfloat16) * 6.4)(B, Hkv, Sk, Dh)),
            "v_cache": _w((lambda *s: torch.randn(*s, dtype=torch.bfloat16) * 0.4)(B, Hkv, Sk, Dh)),
            "wq": _w((lambda *s: torch.randn(*s, dtype=torch.bfloat16) * 6.4)(D, Hq * Dh) * (D ** -0.5)),
            "wo": _w((lambda *s: torch.randn(*s, dtype=torch.bfloat16) * 0.4)(Hq * Dh, D) * ((Hq * Dh) ** -0.5)),
        }
    _A_in = _A_setup()

    def _B_setup():
        B, S, D, Dff = 4, 1, 448, 1792
        return {
            "x": _w((lambda *s: torch.randn(*s, dtype=torch.bfloat16) * 0.05)(B, S, D)),
            "w1": _w((lambda *s: torch.randn(*s, dtype=torch.bfloat16) * 0.05)(D, Dff)),
            "w2": _w((lambda *s: torch.randn(*s, dtype=torch.bfloat16) * 0.05)(Dff, D)),
        }
    _B_in = _B_setup()

    return {
        "A_x": _A_in["x"],
        "A_k_cache": _A_in["k_cache"],
        "A_v_cache": _A_in["v_cache"],
        "A_wq": _A_in["wq"],
        "A_wo": _A_in["wo"],
        "B_x": _B_in["x"],
        "B_w1": _B_in["w1"],
        "B_w2": _B_in["w2"],
        "gate_w": _w((lambda *s: torch.randn(*s, dtype=torch.bfloat16) * 0.05)(448) * 16.0),
    }

def reference(A_x, A_k_cache, A_v_cache, A_wq, A_wo, B_x, B_w1, B_w2, gate_w):
    def _A_ref(x, k_cache, v_cache, wq, wo):
        B, Sq, D = x.shape
        Hq, Dh = 16, 256
        Hkv, Sk = k_cache.shape[1], k_cache.shape[2]
        W = min(4096, max(256, Sk // 4))
        rep = Hq // Hkv
        q = (lambda x, *d: x.permute(*d))((x @ wq).reshape(B, Sq, Hq, Dh), 0, 2, 1, 3)
        k = (lambda x, n, axis: torch.repeat_interleave(x, n, dim=axis))(k_cache[:, :, Sk - W:, :], rep, axis=1)
        v = (lambda x, n, axis: torch.repeat_interleave(x, n, dim=axis))(v_cache[:, :, Sk - W:, :], rep, axis=1)
        scores = torch.einsum("bhqd,bhkd->bhqk", q, k) * (Dh ** -0.5)
        p = _softmax(scores, axis=-1)
        o = torch.einsum("bhqk,bhkd->bhqd", p, v)
        return (lambda x, *d: x.permute(*d))(o, 0, 2, 1, 3).reshape(B, Sq, Hq * Dh) @ wo

    def _B_ref(x, w1, w2):
        h = torch.einsum("bsd,df->bsf", x, w1)
        zero = torch.zeros_like(h)
        h = torch.maximum(h, zero)
        return torch.einsum("bsf,fd->bsd", h, w2)

    x = A_x
    g = _sigmoid((x * gate_w).sum(-1, keepdims=True))
    a = _A_ref(x, A_k_cache, A_v_cache, A_wq, A_wo)
    b = _B_ref(x, B_w1, B_w2)
    return g * a + (1 - g) * b
```

```asm
; @launch grid=(256,1,1) block=(1024,1,1) lds=92160
.amdgcn_target "amdgcn-amd-amdhsa--gfx950"
.text
.globl gated_mix__sliding_block_cached__dense_activation_relu__decode_kernel
.p2align 8
.type gated_mix__sliding_block_cached__dense_activation_relu__decode_kernel,@function
gated_mix__sliding_block_cached__dense_activation_relu__decode_kernel:
    s_cmp_ge_u32 s2, 256
    s_cbranch_scc1 L_end
    s_load_dwordx16 s[4:19], s[0:1], 0
    s_load_dwordx8 s[20:27], s[0:1], 64
    v_lshrrev_b32 v1, 6, v0
    v_and_b32 v2, 63, v0
    v_mov_b32 v9, 0
    v_readfirstlane_b32 s3, v1
    v_mov_b32 v10, 54272
    ds_write_b32 v10, v9
    s_and_b32 s28, s2, 7
    s_lshr_b32 s29, s2, 3
    s_lshr_b32 s30, s29, 3
    s_and_b32 s31, s29, 7
    s_lshl_b32 s34, s30, 3
    s_add_u32 s34, s34, s28
    s_lshl_b32 s34, s34, 22
    s_lshl_b32 s35, s31, 17
    s_add_u32 s34, s34, s35
    s_lshl_b32 s35, s3, 12
    s_add_u32 s34, s34, s35
    s_add_u32 s34, s34, 0x300000
    s_sub_u32 s35, 0x8000000, s34
    v_lshrrev_b32 v11, 4, v2
    v_and_b32 v12, 15, v2
    v_and_b32 v3, 7, v2
    v_lshlrev_b32 v3, 9, v3
    v_lshl_add_u32 v3, v11, 4, v3
    v_bfe_u32 v13, v2, 3, 1
    v_lshl_add_u32 v3, v13, 16, v3
    v_lshlrev_b32 v4, 4, v12
    v_and_b32 v13, 1, v11
    v_lshl_add_u32 v4, v13, 11, v4
    v_lshrrev_b32 v13, 1, v11
    v_lshl_add_u32 v4, v13, 16, v4
    s_mov_b32 s38, 0x0c0c0400
    s_mov_b32 s39, 0x04000c0c
    s_waitcnt lgkmcnt(0)
    s_load_dword s32, s[26:27], 0
    s_add_u32 s40, s6, s34
    s_addc_u32 s41, s7, 0
    s_and_b32 s41, s41, 0xffff
    s_mov_b32 s42, s35
    s_mov_b32 s43, 0x20000
    s_add_u32 s44, s8, s34
    s_addc_u32 s45, s9, 0
    s_and_b32 s45, s45, 0xffff
    s_mov_b32 s46, s35
    s_mov_b32 s47, 0x20000
    s_mov_b32 s48, s26
    s_and_b32 s49, s27, 0xffff
    s_mov_b32 s50, 4194304
    s_mov_b32 s51, 0x20000
    s_cmp_eq_u32 s3, 15
    s_cbranch_scc1 L_w1
    s_cmp_lg_u32 s3, 14
    s_cbranch_scc1 L_kv0
L_w0:
    s_setprio 3
    s_mov_b32 s52, s10
    s_and_b32 s53, s11, 0xffff
    s_mov_b32 s54, 3670016
    s_mov_b32 s55, 0x20000
    s_movk_i32 s64, 8192
    s_mul_i32 s65, s30, 917504
    s_lshl_b32 s36, s28, 10
    s_add_u32 s65, s65, s36
    s_lshl_b32 s36, s31, 7
    s_add_u32 s65, s65, s36
    s_movk_i32 s66, 8192
    s_movk_i32 s67, 0
    s_mov_b32 s68, s30
    s_lshl_b32 s54, s28, 15
    s_lshl_b32 s36, s30, 11
    s_add_u32 s98, s54, s36
    s_lshl_b32 s36, s31, 8
    s_add_u32 s98, s98, s36
    s_add_u32 s98, s98, 4096
    s_movk_i32 s99, 8192
    s_mov_b32 s54, 3670016
    s_branch L_tile
L_w1:
    s_setprio 2
    s_mov_b32 s52, s16
    s_and_b32 s53, s17, 0xffff
    s_mov_b32 s54, 1605632
    s_mov_b32 s55, 0x20000
    s_movk_i32 s64, 3584
    s_lshr_b32 s68, s28, 1
    s_and_b32 s36, s28, 1
    s_mul_i32 s36, s36, 14
    s_add_u32 s36, s36, s29
    s_mul_i32 s65, s68, 401408
    s_lshl_b32 s37, s36, 7
    s_add_u32 s65, s65, s37
    s_movk_i32 s66, 22528
    s_movk_i32 s67, 4096
    s_mul_i32 s98, s68, 7168
    s_lshl_b32 s36, s36, 8
    s_add_u32 s98, s98, s36
    s_add_u32 s98, s98, 270336
    s_movk_i32 s99, 28672
    s_mov_b32 s56, s20
    s_and_b32 s57, s21, 0xffff
    s_mov_b32 s58, 896
    s_mov_b32 s59, 0x20000
    v_lshlrev_b32 v14, 4, v2
    s_mov_b32 m0, 36864
    s_mov_b32 s60, 0
    buffer_load_dwordx4 v14, s[56:59], s60 offen  lds
L_tile:
    s_mov_b32 s56, s4
    s_and_b32 s57, s5, 0xffff
    s_mov_b32 s58, 3584
    s_mov_b32 s59, 0x20000
    v_lshlrev_b32 v14, 4, v2
    s_mov_b32 m0, s67
    s_nop 0
    buffer_load_dwordx4 v14, s[56:59], 0 offen offset:0  lds
    buffer_load_dwordx4 v14, s[56:59], 0 offen offset:1024  lds
    buffer_load_dwordx4 v14, s[56:59], 0 offen offset:2048  lds
    buffer_load_dwordx4 v14, s[56:59], 0 offen offset:3072  lds
    s_cmp_eq_u32 s3, 14
    s_cbranch_scc1 L_tile2
    s_cmp_ge_u32 s29, 14
    s_cbranch_scc1 L_xcopy
L_tile2:
    v_lshrrev_b32 v13, 3, v2
    v_mul_lo_u32 v13, v13, s64
    v_and_b32 v14, 7, v2
    v_lshl_add_u32 v13, v14, 4, v13
    s_mov_b32 m0, s66
    s_lshl_b32 s37, s64, 3
    s_mov_b32 s60, s65
    buffer_load_dwordx4 v13, s[52:55], s60 offen nt lds
    s_add_u32 m0, m0, 1024
    s_add_u32 s60, s60, s37
    buffer_load_dwordx4 v13, s[52:55], s60 offen nt lds
    s_add_u32 m0, m0, 1024
    s_add_u32 s60, s60, s37
    buffer_load_dwordx4 v13, s[52:55], s60 offen nt lds
    s_add_u32 m0, m0, 1024
    s_add_u32 s60, s60, s37
    buffer_load_dwordx4 v13, s[52:55], s60 offen nt lds
    s_add_u32 m0, m0, 1024
    s_add_u32 s60, s60, s37
    buffer_load_dwordx4 v13, s[52:55], s60 offen nt lds
    s_add_u32 m0, m0, 1024
    s_add_u32 s60, s60, s37
    buffer_load_dwordx4 v13, s[52:55], s60 offen nt lds
    s_add_u32 m0, m0, 1024
    s_add_u32 s60, s60, s37
    buffer_load_dwordx4 v13, s[52:55], s60 offen nt lds
    s_add_u32 m0, m0, 1024
    s_add_u32 s60, s60, s37
    buffer_load_dwordx4 v13, s[52:55], s60 offen nt lds
    s_add_u32 m0, m0, 1024
    s_add_u32 s60, s60, s37
    buffer_load_dwordx4 v13, s[52:55], s60 offen nt lds
    s_add_u32 m0, m0, 1024
    s_add_u32 s60, s60, s37
    buffer_load_dwordx4 v13, s[52:55], s60 offen nt lds
    s_add_u32 m0, m0, 1024
    s_add_u32 s60, s60, s37
    buffer_load_dwordx4 v13, s[52:55], s60 offen nt lds
    s_add_u32 m0, m0, 1024
    s_add_u32 s60, s60, s37
    buffer_load_dwordx4 v13, s[52:55], s60 offen nt lds
    s_add_u32 m0, m0, 1024
    s_add_u32 s60, s60, s37
    buffer_load_dwordx4 v13, s[52:55], s60 offen nt lds
    s_add_u32 m0, m0, 1024
    s_add_u32 s60, s60, s37
    buffer_load_dwordx4 v13, s[52:55], s60 offen nt lds
L_xcopy:
    s_barrier
    s_waitcnt lgkmcnt(0)
    s_mul_i32 s33, s32, 1664525
    s_add_u32 s33, s33, 1013904223
    s_cmp_eq_u32 s3, 14
    s_cbranch_scc1 L_q
L_h:
    s_cmp_ge_u32 s29, 14
    s_cbranch_scc1 L_gate
L_q:
    v_lshrrev_b32 v13, 2, v12
    v_lshl_add_u32 v13, v11, 2, v13
    v_lshlrev_b32 v13, 7, v13
    v_and_b32 v14, 3, v12
    v_lshl_add_u32 v13, v14, 3, v13
    v_add_u32 v13, s66, v13
    s_mul_i32 s36, s68, 224
    s_add_u32 s36, s36, s67
    v_and_b32 v14, 3, v2
    v_mul_u32_u24 v14, 896, v14
    v_lshl_add_u32 v14, v11, 3, v14
    v_add_u32 v14, s36, v14
    v_mul_lo_u32 v15, v12, s99
    v_lshl_add_u32 v15, v11, 4, v15
    v_add_u32 v15, s98, v15
    s_and_b32 s36, s33, 0xff
    s_bfe_u32 s37, s33, 0x80008
    s_bfe_u32 s60, s33, 0x80010
    s_lshr_b32 s61, s33, 24
    v_mov_b32 v9, 0xff
    s_waitcnt vmcnt(0)
    ds_read_b64 v[32:33], v14 offset:0
    ds_read_b64_tr_b16 v[34:35], v13 offset:0
    ds_read_b64_tr_b16 v[36:37], v13 offset:32
    ds_read_b64_tr_b16 v[38:39], v13 offset:64
    ds_read_b64_tr_b16 v[40:41], v13 offset:96
    ds_read_b64 v[42:43], v14 offset:32
    ds_read_b64_tr_b16 v[44:45], v13 offset:2048
    ds_read_b64_tr_b16 v[46:47], v13 offset:2080
    ds_read_b64_tr_b16 v[48:49], v13 offset:2112
    ds_read_b64_tr_b16 v[50:51], v13 offset:2144
    ds_read_b64 v[52:53], v14 offset:64
    ds_read_b64_tr_b16 v[54:55], v13 offset:4096
    ds_read_b64_tr_b16 v[56:57], v13 offset:4128
    ds_read_b64_tr_b16 v[58:59], v13 offset:4160
    ds_read_b64_tr_b16 v[60:61], v13 offset:4192
    s_waitcnt lgkmcnt(10)
    v_mfma_f32_16x16x16_bf16 v[16:19], v[34:35], v[32:33], 0
    v_mfma_f32_16x16x16_bf16 v[20:23], v[36:37], v[32:33], 0
    v_mfma_f32_16x16x16_bf16 v[24:27], v[38:39], v[32:33], 0
    v_mfma_f32_16x16x16_bf16 v[28:31], v[40:41], v[32:33], 0
    ds_read_b64 v[32:33], v14 offset:96
    ds_read_b64_tr_b16 v[34:35], v13 offset:6144
    ds_read_b64_tr_b16 v[36:37], v13 offset:6176
    ds_read_b64_tr_b16 v[38:39], v13 offset:6208
    ds_read_b64_tr_b16 v[40:41], v13 offset:6240
    s_waitcnt lgkmcnt(10)
    v_mfma_f32_16x16x16_bf16 v[16:19], v[44:45], v[42:43], v[16:19]
    v_mfma_f32_16x16x16_bf16 v[20:23], v[46:47], v[42:43], v[20:23]
    v_mfma_f32_16x16x16_bf16 v[24:27], v[48:49], v[42:43], v[24:27]
    v_mfma_f32_16x16x16_bf16 v[28:31], v[50:51], v[42:43], v[28:31]
    ds_read_b64 v[42:43], v14 offset:128
    ds_read_b64_tr_b16 v[44:45], v13 offset:8192
    ds_read_b64_tr_b16 v[46:47], v13 offset:8224
    ds_read_b64_tr_b16 v[48:49], v13 offset:8256
    ds_read_b64_tr_b16 v[50:51], v13 offset:8288
    s_waitcnt lgkmcnt(10)
    v_mfma_f32_16x16x16_bf16 v[16:19], v[54:55], v[52:53], v[16:19]
    v_mfma_f32_16x16x16_bf16 v[20:23], v[56:57], v[52:53], v[20:23]
    v_mfma_f32_16x16x16_bf16 v[24:27], v[58:59], v[52:53], v[24:27]
    v_mfma_f32_16x16x16_bf16 v[28:31], v[60:61], v[52:53], v[28:31]
    ds_read_b64 v[52:53], v14 offset:160
    ds_read_b64_tr_b16 v[54:55], v13 offset:10240
    ds_read_b64_tr_b16 v[56:57], v13 offset:10272
    ds_read_b64_tr_b16 v[58:59], v13 offset:10304
    ds_read_b64_tr_b16 v[60:61], v13 offset:10336
    s_waitcnt lgkmcnt(10)
    v_mfma_f32_16x16x16_bf16 v[16:19], v[34:35], v[32:33], v[16:19]
    v_mfma_f32_16x16x16_bf16 v[20:23], v[36:37], v[32:33], v[20:23]
    v_mfma_f32_16x16x16_bf16 v[24:27], v[38:39], v[32:33], v[24:27]
    v_mfma_f32_16x16x16_bf16 v[28:31], v[40:41], v[32:33], v[28:31]
    ds_read_b64 v[32:33], v14 offset:192
    ds_read_b64_tr_b16 v[34:35], v13 offset:12288
    ds_read_b64_tr_b16 v[36:37], v13 offset:12320
    ds_read_b64_tr_b16 v[38:39], v13 offset:12352
    ds_read_b64_tr_b16 v[40:41], v13 offset:12384
    s_waitcnt lgkmcnt(10)
    v_mfma_f32_16x16x16_bf16 v[16:19], v[44:45], v[42:43], v[16:19]
    v_mfma_f32_16x16x16_bf16 v[20:23], v[46:47], v[42:43], v[20:23]
    v_mfma_f32_16x16x16_bf16 v[24:27], v[48:49], v[42:43], v[24:27]
    v_mfma_f32_16x16x16_bf16 v[28:31], v[50:51], v[42:43], v[28:31]
    s_waitcnt lgkmcnt(5)
    v_mfma_f32_16x16x16_bf16 v[16:19], v[54:55], v[52:53], v[16:19]
    v_mfma_f32_16x16x16_bf16 v[20:23], v[56:57], v[52:53], v[20:23]
    v_mfma_f32_16x16x16_bf16 v[24:27], v[58:59], v[52:53], v[24:27]
    v_mfma_f32_16x16x16_bf16 v[28:31], v[60:61], v[52:53], v[28:31]
    s_waitcnt lgkmcnt(0)
    v_mfma_f32_16x16x16_bf16 v[16:19], v[34:35], v[32:33], v[16:19]
    v_mfma_f32_16x16x16_bf16 v[20:23], v[36:37], v[32:33], v[20:23]
    v_mfma_f32_16x16x16_bf16 v[24:27], v[38:39], v[32:33], v[24:27]
    v_mfma_f32_16x16x16_bf16 v[28:31], v[40:41], v[32:33], v[28:31]
    s_nop 4
    s_mov_b32 exec_lo, 0x000f000f
    s_mov_b32 exec_hi, 0x000f000f
    v_bfi_b32 v16, v9, s36, v16
    v_bfi_b32 v17, v9, s37, v17
    v_bfi_b32 v18, v9, s60, v18
    v_bfi_b32 v19, v9, s61, v19
    v_bfi_b32 v20, v9, s36, v20
    v_bfi_b32 v21, v9, s37, v21
    v_bfi_b32 v22, v9, s60, v22
    v_bfi_b32 v23, v9, s61, v23
    v_bfi_b32 v24, v9, s36, v24
    v_bfi_b32 v25, v9, s37, v25
    v_bfi_b32 v26, v9, s60, v26
    v_bfi_b32 v27, v9, s61, v27
    v_bfi_b32 v28, v9, s36, v28
    v_bfi_b32 v29, v9, s37, v29
    v_bfi_b32 v30, v9, s60, v30
    v_bfi_b32 v31, v9, s61, v31
    s_cmp_lg_u32 s3, 14
    s_cbranch_scc1 L_sth
    buffer_store_dwordx4 v[16:19], v15, s[48:51], 0 offen offset:0
    buffer_store_dwordx4 v[20:23], v15, s[48:51], 0 offen offset:64
    buffer_store_dwordx4 v[24:27], v15, s[48:51], 0 offen offset:128
    buffer_store_dwordx4 v[28:31], v15, s[48:51], 0 offen offset:192
    s_branch L_std
L_sth:
    buffer_store_dwordx4 v[16:19], v15, s[48:51], 0 offen offset:0 sc0 sc1
    buffer_store_dwordx4 v[20:23], v15, s[48:51], 0 offen offset:64 sc0 sc1
    buffer_store_dwordx4 v[24:27], v15, s[48:51], 0 offen offset:128 sc0 sc1
    buffer_store_dwordx4 v[28:31], v15, s[48:51], 0 offen offset:192 sc0 sc1
L_std:
    s_mov_b64 exec, -1
    s_cmp_eq_u32 s3, 14
    s_cbranch_scc1 L_kv
L_gate:
    v_and_b32 v14, 3, v2
    v_mul_u32_u24 v14, 896, v14
    v_lshl_add_u32 v14, v11, 4, v14
    v_lshlrev_b32 v13, 4, v11
    s_cmp_lt_u32 s29, 14
    s_cbranch_scc1 L_gate2
    s_waitcnt vmcnt(0)
L_gate2:
    ds_read_b128 v[32:35], v13 offset:36864
    ds_read_b128 v[36:39], v14 offset:4096
    ds_read_b128 v[40:43], v13 offset:36928
    ds_read_b128 v[44:47], v14 offset:4160
    ds_read_b128 v[48:51], v13 offset:36992
    ds_read_b128 v[52:55], v14 offset:4224
    ds_read_b128 v[56:59], v13 offset:37056
    ds_read_b128 v[60:63], v14 offset:4288
    s_waitcnt lgkmcnt(0)
    v_mfma_f32_16x16x32_bf16 v[20:23], v[32:35], v[36:39], 0
    v_mfma_f32_16x16x32_bf16 v[20:23], v[40:43], v[44:47], v[20:23]
    v_mfma_f32_16x16x32_bf16 v[20:23], v[48:51], v[52:55], v[20:23]
    v_mfma_f32_16x16x32_bf16 v[20:23], v[56:59], v[60:63], v[20:23]
    ds_read_b128 v[32:35], v13 offset:37120
    ds_read_b128 v[36:39], v14 offset:4352
    ds_read_b128 v[40:43], v13 offset:37184
    ds_read_b128 v[44:47], v14 offset:4416
    ds_read_b128 v[48:51], v13 offset:37248
    ds_read_b128 v[52:55], v14 offset:4480
    ds_read_b128 v[56:59], v13 offset:37312
    ds_read_b128 v[60:63], v14 offset:4544
    s_waitcnt lgkmcnt(0)
    v_mfma_f32_16x16x32_bf16 v[20:23], v[32:35], v[36:39], v[20:23]
    v_mfma_f32_16x16x32_bf16 v[20:23], v[40:43], v[44:47], v[20:23]
    v_mfma_f32_16x16x32_bf16 v[20:23], v[48:51], v[52:55], v[20:23]
    v_mfma_f32_16x16x32_bf16 v[20:23], v[56:59], v[60:63], v[20:23]
    ds_read_b128 v[32:35], v13 offset:37376
    ds_read_b128 v[36:39], v14 offset:4608
    ds_read_b128 v[40:43], v13 offset:37440
    ds_read_b128 v[44:47], v14 offset:4672
    ds_read_b128 v[48:51], v13 offset:37504
    ds_read_b128 v[52:55], v14 offset:4736
    ds_read_b128 v[56:59], v13 offset:37568
    ds_read_b128 v[60:63], v14 offset:4800
    s_waitcnt lgkmcnt(0)
    v_mfma_f32_16x16x32_bf16 v[20:23], v[32:35], v[36:39], v[20:23]
    v_mfma_f32_16x16x32_bf16 v[20:23], v[40:43], v[44:47], v[20:23]
    v_mfma_f32_16x16x32_bf16 v[20:23], v[48:51], v[52:55], v[20:23]
    v_mfma_f32_16x16x32_bf16 v[20:23], v[56:59], v[60:63], v[20:23]
    ds_read_b128 v[32:35], v13 offset:37632
    ds_read_b128 v[36:39], v14 offset:4864
    ds_read_b128 v[40:43], v13 offset:37696
    ds_read_b128 v[44:47], v14 offset:4928
    s_waitcnt lgkmcnt(0)
    v_mfma_f32_16x16x32_bf16 v[20:23], v[32:35], v[36:39], v[20:23]
    v_mfma_f32_16x16x32_bf16 v[20:23], v[40:43], v[44:47], v[20:23]
    s_nop 7
    v_cvt_pk_bf16_f32 v20, 0, v20
    v_mul_f32 v20, 0xbfb8aa3b, v20
    v_exp_f32 v20, v20
    s_nop 0
    v_add_f32 v20, 1.0, v20
    v_rcp_f32 v20, v20
    s_nop 0
    v_cvt_pk_bf16_f32 v20, 0, v20
    v_lshlrev_b32 v14, 2, v12
    s_mov_b64 exec, 0xf
    ds_write_b32 v14, v20 offset:54336
    s_mov_b64 exec, -1
    s_branch L_kv
L_kv0:
    s_barrier
L_kv:
    s_setprio 0
    buffer_load_dwordx4 v[64:67], v3, s[40:43], 0 offen offset:0 nt
    v_and_b32 v13, 1, v2
    v_lshlrev_b32 v13, 4, v13
    buffer_load_dwordx4 v[68:71], v3, s[40:43], 0 offen offset:64 nt
    v_mov_b32 v14, 0xffff
    buffer_load_dwordx4 v[72:75], v3, s[40:43], 0 offen offset:128 nt
    v_lshlrev_b32 v14, v13, v14
    v_bfe_u32 v13, v2, 1, 2
    buffer_load_dwordx4 v[76:79], v3, s[40:43], 0 offen offset:192 nt
    v_cmp_eq_u32 vcc, 0, v13
    buffer_load_dwordx4 v[80:83], v3, s[40:43], 0 offen offset:256 nt
    v_cndmask_b32 v5, 0, v14, vcc
    v_cmp_eq_u32 vcc, 1, v13
    buffer_load_dwordx4 v[84:87], v3, s[40:43], 0 offen offset:320 nt
    v_cndmask_b32 v6, 0, v14, vcc
    v_cmp_eq_u32 vcc, 2, v13
    buffer_load_dwordx4 v[88:91], v3, s[40:43], 0 offen offset:384 nt
    v_cndmask_b32 v7, 0, v14, vcc
    v_cmp_eq_u32 vcc, 3, v13
    buffer_load_dwordx4 v[92:95], v3, s[40:43], 0 offen offset:448 nt
    v_cndmask_b32 v8, 0, v14, vcc
    v_bfe_u32 v0, v2, 3, 1
    buffer_load_dwordx4 v[96:99], v4, s[44:47], 0 offen offset:0 nt
    v_lshlrev_b32 v0, 9, v0
    buffer_load_dwordx4 v[100:103], v4, s[44:47], 0 offen offset:256 nt
    v_lshl_add_u32 v0, v11, 4, v0
    v_lshrrev_b32 v1, 1, v11
    buffer_load_dwordx4 v[104:107], v4, s[44:47], 0 offen offset:512 nt
    v_lshlrev_b32 v1, 10, v1
    buffer_load_dwordx4 v[108:111], v4, s[44:47], 0 offen offset:768 nt
    v_lshl_add_u32 v1, v12, 5, v1
    v_and_b32 v14, 1, v11
    buffer_load_dwordx4 v[112:115], v4, s[44:47], 0 offen offset:1024 nt
    v_lshl_add_u32 v1, v14, 4, v1
    buffer_load_dwordx4 v[116:119], v4, s[44:47], 0 offen offset:1280 nt
    v_mov_b32 v14, 2112
    v_mad_u32_u24 v1, s3, v14, v1
    buffer_load_dwordx4 v[120:123], v4, s[44:47], 0 offen offset:1536 nt
    v_lshlrev_b32 v9, 3, v2
    v_lshl_add_u32 v9, s3, 2, v9
    buffer_load_dwordx4 v[124:127], v4, s[44:47], 0 offen offset:1792 nt
    s_waitcnt lgkmcnt(0)
    s_mul_i32 s33, s32, 1664525
    s_add_u32 s33, s33, 1013904223
    s_cmp_eq_u32 s3, 9
    s_cbranch_scc1 L_hg
    s_cmp_lg_u32 s3, 8
    s_cbranch_scc1 L_waitq
    s_lshl_b32 s36, s28, 15
    s_lshl_b32 s37, s30, 13
    s_add_u32 s36, s36, s37
    s_add_u32 s36, s36, 4096
    s_add_u32 s37, s36, 4096
    v_lshlrev_b32 v13, 4, v2
    s_mov_b32 s61, 0
    s_branch L_qp0
L_qpoll:
    s_and_b32 s60, s61, 31
    s_cbranch_scc1 L_qp0
    buffer_wbl2 sc1
    s_waitcnt vmcnt(0)
L_qp0:
    buffer_load_dwordx4 v[32:35], v13, s[48:51], s36 offen offset:0 sc0 sc1
    buffer_load_dwordx4 v[36:39], v13, s[48:51], s36 offen offset:1024 sc0 sc1
    buffer_load_dwordx4 v[40:43], v13, s[48:51], s36 offen offset:2048 sc0 sc1
    buffer_load_dwordx4 v[44:47], v13, s[48:51], s36 offen offset:3072 sc0 sc1
    buffer_load_dwordx4 v[48:51], v13, s[48:51], s37 offen offset:0 sc0 sc1
    buffer_load_dwordx4 v[52:55], v13, s[48:51], s37 offen offset:1024 sc0 sc1
    buffer_load_dwordx4 v[56:59], v13, s[48:51], s37 offen offset:2048 sc0 sc1
    buffer_load_dwordx4 v[60:63], v13, s[48:51], s37 offen offset:3072 sc0 sc1
    s_add_u32 s61, s61, 1
    s_waitcnt vmcnt(0)
    v_perm_b32 v14, v33, v32, s38
    v_perm_b32 v15, v35, v34, s39
    v_or_b32 v14, v14, v15
    v_cmp_ne_u32 s[62:63], s33, v14
    v_perm_b32 v14, v37, v36, s38
    v_perm_b32 v15, v39, v38, s39
    v_or_b32 v14, v14, v15
    v_cmp_ne_u32 vcc, s33, v14
    s_or_b64 s[62:63], s[62:63], vcc
    v_perm_b32 v14, v41, v40, s38
    v_perm_b32 v15, v43, v42, s39
    v_or_b32 v14, v14, v15
    v_cmp_ne_u32 vcc, s33, v14
    s_or_b64 s[62:63], s[62:63], vcc
    v_perm_b32 v14, v45, v44, s38
    v_perm_b32 v15, v47, v46, s39
    v_or_b32 v14, v14, v15
    v_cmp_ne_u32 vcc, s33, v14
    s_or_b64 s[62:63], s[62:63], vcc
    v_perm_b32 v14, v49, v48, s38
    v_perm_b32 v15, v51, v50, s39
    v_or_b32 v14, v14, v15
    v_cmp_ne_u32 vcc, s33, v14
    s_or_b64 s[62:63], s[62:63], vcc
    v_perm_b32 v14, v53, v52, s38
    v_perm_b32 v15, v55, v54, s39
    v_or_b32 v14, v14, v15
    v_cmp_ne_u32 vcc, s33, v14
    s_or_b64 s[62:63], s[62:63], vcc
    v_perm_b32 v14, v57, v56, s38
    v_perm_b32 v15, v59, v58, s39
    v_or_b32 v14, v14, v15
    v_cmp_ne_u32 vcc, s33, v14
    s_or_b64 s[62:63], s[62:63], vcc
    v_perm_b32 v14, v61, v60, s38
    v_perm_b32 v15, v63, v62, s39
    v_or_b32 v14, v14, v15
    v_cmp_ne_u32 vcc, s33, v14
    s_or_b64 s[62:63], s[62:63], vcc
    s_cmp_gt_u32 s61, 16384
    s_cbranch_scc1 L_qgot
    s_and_b64 exec, exec, s[62:63]
    s_cbranch_scc1 L_qpoll
L_qgot:
    s_mov_b64 exec, -1
    v_add_f32 v32, v32, v40
    v_add_f32 v48, v48, v56
    v_add_f32 v33, v33, v41
    v_add_f32 v49, v49, v57
    v_add_f32 v34, v34, v42
    v_add_f32 v50, v50, v58
    v_add_f32 v35, v35, v43
    v_add_f32 v51, v51, v59
    v_add_f32 v36, v36, v44
    v_add_f32 v52, v52, v60
    v_add_f32 v37, v37, v45
    v_add_f32 v53, v53, v61
    v_add_f32 v38, v38, v46
    v_add_f32 v54, v54, v62
    v_add_f32 v39, v39, v47
    v_add_f32 v55, v55, v63
    v_add_f32 v32, v32, v48
    v_add_f32 v33, v33, v49
    v_add_f32 v34, v34, v50
    v_add_f32 v35, v35, v51
    v_add_f32 v36, v36, v52
    v_add_f32 v37, v37, v53
    v_add_f32 v38, v38, v54
    v_add_f32 v39, v39, v55
    v_cvt_pk_bf16_f32 v32, v32, v33
    v_cvt_pk_bf16_f32 v33, v34, v35
    v_cvt_pk_bf16_f32 v34, v36, v37
    v_cvt_pk_bf16_f32 v35, v38, v39
    v_lshlrev_b32 v13, 3, v2
    ds_write_b64 v13, v[32:33] offset:52224
    ds_write_b64 v13, v[34:35] offset:52736
    v_mov_b32 v14, 1
    s_waitcnt lgkmcnt(0)
    ds_write_b32 v10, v14
    s_branch L_main
L_hg:
    s_sub_u32 s37, s29, 14
    s_cmp_ge_u32 s37, 14
    s_cbranch_scc1 L_waitq
    v_bfe_u32 v14, v2, 2, 2
    v_lshl_add_u32 v13, v14, 2, v11
    v_mul_u32_u24 v13, 7168, v13
    v_and_b32 v15, 3, v2
    v_lshl_add_u32 v13, v15, 4, v13
    s_mul_i32 s36, s28, 14
    s_add_u32 s36, s36, s37
    s_lshl_b32 s36, s36, 6
    s_add_u32 s36, s36, 270336
    v_lshrrev_b32 v16, 1, v11
    v_and_b32 v17, 1, v11
    v_lshl_add_u32 v16, v17, 1, v16
    v_lshlrev_b32 v16, 2, v16
    v_lshl_add_u32 v16, v12, 4, v16
    s_mov_b32 s61, 0
L_hpoll:
    buffer_load_dwordx4 v[32:35], v13, s[48:51], s36 offen sc0 sc1
    s_add_u32 s61, s61, 1
    s_waitcnt vmcnt(0)
    v_perm_b32 v14, v33, v32, s38
    v_perm_b32 v15, v35, v34, s39
    v_or_b32 v14, v14, v15
    v_cmp_ne_u32 s[62:63], s33, v14
    s_cmp_gt_u32 s61, 16384
    s_cbranch_scc1 L_hgot
    s_and_b64 exec, exec, s[62:63]
    s_cbranch_scc1 L_hpoll
L_hgot:
    s_mov_b64 exec, -1
    v_permlane32_swap_b32 v32, v33
    v_permlane32_swap_b32 v34, v35
    v_add_f32 v32, v32, v33
    v_add_f32 v34, v34, v35
    s_nop 1
    v_permlane16_swap_b32 v32, v34
    v_add_f32 v32, v32, v34
    v_max_f32 v32, 0, v32
    v_cvt_pk_bf16_f32 v32, v32, v32
    ds_write_b32 v16, v32 offset:54528
L_waitq:
    s_mov_b32 s61, 0
L_qspin:
    ds_read_b32 v14, v10
    s_add_u32 s61, s61, 1
    s_waitcnt lgkmcnt(0)
    v_readfirstlane_b32 s36, v14
    s_cmp_gt_u32 s61, 65536
    s_cbranch_scc1 L_main
    s_cmp_lg_u32 s36, 0
    s_cbranch_scc1 L_main
    s_sleep 2
    s_branch L_qspin
L_main:
    ds_read_b128 v[32:35], v0 offset:52224
    ds_read_b128 v[36:39], v0 offset:52288
    ds_read_b128 v[40:43], v0 offset:52352
    ds_read_b128 v[44:47], v0 offset:52416
    ds_read_b128 v[48:51], v0 offset:52480
    ds_read_b128 v[52:55], v0 offset:52544
    ds_read_b128 v[56:59], v0 offset:52608
    ds_read_b128 v[60:63], v0 offset:52672
    s_waitcnt vmcnt(8) lgkmcnt(0)
    v_mfma_f32_16x16x32_bf16 v[16:19], v[64:67], v[32:35], 0
    v_mfma_f32_16x16x32_bf16 v[16:19], v[68:71], v[36:39], v[16:19]
    v_mfma_f32_16x16x32_bf16 v[16:19], v[72:75], v[40:43], v[16:19]
    v_mfma_f32_16x16x32_bf16 v[16:19], v[76:79], v[44:47], v[16:19]
    v_mfma_f32_16x16x32_bf16 v[16:19], v[80:83], v[48:51], v[16:19]
    v_mfma_f32_16x16x32_bf16 v[16:19], v[84:87], v[52:55], v[16:19]
    v_mfma_f32_16x16x32_bf16 v[16:19], v[88:91], v[56:59], v[16:19]
    v_mfma_f32_16x16x32_bf16 v[16:19], v[92:95], v[60:63], v[16:19]
    s_cmp_lt_u32 s3, 12
    s_cbranch_scc1 L_now
    s_mov_b32 s52, s12
    s_and_b32 s53, s13, 0xffff
    s_mov_b32 s54, 3670016
    s_mov_b32 s55, 0x20000
    s_mov_b32 s56, s18
    s_and_b32 s57, s19, 0xffff
    s_mov_b32 s58, 1605632
    s_mov_b32 s59, 0x20000
    s_sub_u32 s37, s29, 14
    s_cmp_ge_u32 s37, 14
    s_cselect_b32 s58, 0, s58
    s_mul_i32 s65, s28, 14
    s_add_u32 s65, s65, s37
    s_mul_i32 s65, s65, 14336
    s_lshl_b32 s64, s28, 5
    s_add_u32 s64, s64, s29
    s_mul_i32 s64, s64, 14336
    s_and_b32 s36, s3, 3
    s_lshl_b32 s36, s36, 8
    v_mul_u32_u24 v14, 3584, v11
    v_lshl_add_u32 v14, v12, 4, v14
    v_add_u32 v14, s36, v14
    buffer_load_dwordx4 v[64:67], v14, s[52:55], s64 offen offset:0 nt
    buffer_load_dwordx4 v[68:71], v14, s[52:55], s64 offen offset:896 nt
    buffer_load_dwordx4 v[72:75], v14, s[52:55], s64 offen offset:1792 nt
    buffer_load_dwordx4 v[76:79], v14, s[52:55], s64 offen offset:2688 nt
    buffer_load_dwordx4 v[80:83], v14, s[56:59], s65 offen offset:0 nt
    buffer_load_dwordx4 v[84:87], v14, s[56:59], s65 offen offset:896 nt
    buffer_load_dwordx4 v[88:91], v14, s[56:59], s65 offen offset:1792 nt
    buffer_load_dwordx4 v[92:95], v14, s[56:59], s65 offen offset:2688 nt
L_now:
    s_mov_b32 s36, 0x3db8aa3b
    s_mov_b32 s37, 0xffff0000
    s_nop 5
    v_cvt_pk_bf16_f32 v20, v16, v17
    v_cvt_pk_bf16_f32 v21, v18, v19
    v_lshlrev_b32 v16, 16, v20
    v_and_b32 v17, s37, v20
    v_lshlrev_b32 v18, 16, v21
    v_and_b32 v19, s37, v21
    v_mul_f32 v16, s36, v16
    v_mul_f32 v17, s36, v17
    v_mul_f32 v18, s36, v18
    v_mul_f32 v19, s36, v19
    v_max_f32 v20, v16, v17
    v_max3_f32 v20, v20, v18, v19
    v_mov_b32 v21, v20
    s_nop 1
    v_permlane32_swap_b32 v20, v21
    v_max_f32 v20, v20, v21
    v_mov_b32 v21, v20
    s_nop 1
    v_permlane16_swap_b32 v20, v21
    v_max_f32 v20, v20, v21
    v_sub_f32 v16, v16, v20
    v_sub_f32 v17, v17, v20
    v_sub_f32 v18, v18, v20
    v_sub_f32 v19, v19, v20
    v_exp_f32 v16, v16
    v_exp_f32 v17, v17
    v_exp_f32 v18, v18
    v_exp_f32 v19, v19
    v_add_f32 v21, v16, v17
    v_add_f32 v22, v18, v19
    v_add_f32 v21, v21, v22
    v_cvt_pk_bf16_f32 v16, v16, v16
    v_cvt_pk_bf16_f32 v17, v17, v17
    v_cvt_pk_bf16_f32 v18, v18, v18
    v_cvt_pk_bf16_f32 v19, v19, v19
    v_and_b32 v32, v16, v5
    v_and_b32 v33, v16, v6
    v_and_b32 v34, v16, v7
    v_and_b32 v35, v16, v8
    v_and_b32 v36, v17, v5
    v_and_b32 v37, v17, v6
    v_and_b32 v38, v17, v7
    v_and_b32 v39, v17, v8
    v_and_b32 v40, v18, v5
    v_and_b32 v41, v18, v6
    v_and_b32 v42, v18, v7
    v_and_b32 v43, v18, v8
    v_and_b32 v44, v19, v5
    v_and_b32 v45, v19, v6
    v_and_b32 v46, v19, v7
    v_and_b32 v47, v19, v8
    v_mov_b32 v22, v21
    s_nop 1
    v_permlane32_swap_b32 v21, v22
    v_add_f32 v21, v21, v22
    v_mov_b32 v22, v21
    s_nop 1
    v_permlane16_swap_b32 v21, v22
    v_add_f32 v21, v21, v22
    s_mov_b64 exec, 0x101
    ds_write_b32 v9, v20 offset:53248
    ds_write_b32 v9, v21 offset:53376
    s_mov_b64 exec, -1
    s_cmp_lt_u32 s3, 12
    s_cbranch_scc1 L_pv0
    s_waitcnt vmcnt(14)
    v_mfma_f32_16x16x32_bf16 v[24:27], v[32:35], v[96:99], 0
    v_mfma_f32_16x16x32_bf16 v[28:31], v[32:35], v[100:103], 0
    s_waitcnt vmcnt(12)
    v_mfma_f32_16x16x32_bf16 v[24:27], v[36:39], v[104:107], v[24:27]
    v_mfma_f32_16x16x32_bf16 v[28:31], v[36:39], v[108:111], v[28:31]
    s_waitcnt vmcnt(10)
    v_mfma_f32_16x16x32_bf16 v[24:27], v[40:43], v[112:115], v[24:27]
    v_mfma_f32_16x16x32_bf16 v[28:31], v[40:43], v[116:119], v[28:31]
    s_waitcnt vmcnt(8)
    v_mfma_f32_16x16x32_bf16 v[24:27], v[44:47], v[120:123], v[24:27]
    v_mfma_f32_16x16x32_bf16 v[28:31], v[44:47], v[124:127], v[28:31]
    s_branch L_pv1
L_pv0:
    s_waitcnt vmcnt(6)
    v_mfma_f32_16x16x32_bf16 v[24:27], v[32:35], v[96:99], 0
    v_mfma_f32_16x16x32_bf16 v[28:31], v[32:35], v[100:103], 0
    s_waitcnt vmcnt(4)
    v_mfma_f32_16x16x32_bf16 v[24:27], v[36:39], v[104:107], v[24:27]
    v_mfma_f32_16x16x32_bf16 v[28:31], v[36:39], v[108:111], v[28:31]
    s_waitcnt vmcnt(2)
    v_mfma_f32_16x16x32_bf16 v[24:27], v[40:43], v[112:115], v[24:27]
    v_mfma_f32_16x16x32_bf16 v[28:31], v[40:43], v[116:119], v[28:31]
    s_waitcnt vmcnt(0)
    v_mfma_f32_16x16x32_bf16 v[24:27], v[44:47], v[120:123], v[24:27]
    v_mfma_f32_16x16x32_bf16 v[28:31], v[44:47], v[124:127], v[28:31]
L_pv1:
    s_nop 6
    ds_write_b128 v1, v[24:27] offset:57344
    ds_write_b128 v1, v[28:31] offset:57856
    s_cmp_ge_u32 s3, 12
    s_cbranch_scc1 L_pre
    s_cmp_ge_u32 s3, 7
    s_cbranch_scc1 L_idle
    s_cmp_eq_u32 s3, 6
    s_cbranch_scc1 L_hop1
    s_and_b32 s60, s33, 0xff
    s_bfe_u32 s61, s33, 0x80008
    s_bfe_u32 s64, s33, 0x80010
    s_lshr_b32 s65, s33, 24
    v_mov_b32 v9, 0xff
    s_mul_i32 s36, s2, 2176
    s_add_u32 s36, s36, 393216
    s_mov_b32 s66, 0xffffff00
    s_cmp_ge_u32 s3, 4
    s_cbranch_scc1 L_stat
    s_lshr_b32 s37, s3, 1
    s_lshl_b32 s37, s37, 6
    v_mov_b32 v14, s37
    v_lshrrev_b32 v15, 3, v2
    v_lshl_add_u32 v16, v15, 3, v14
    v_mul_u32_u24 v15, 4224, v15
    v_and_b32 v17, 7, v2
    v_lshl_add_u32 v15, v17, 4, v15
    s_lshl_b32 s37, s3, 9
    v_add_u32 v15, s37, v15
    s_add_u32 s36, s36, s37
    v_lshlrev_b32 v21, 4, v17
    v_lshl_add_u32 v21, v11, 7, v21
    s_waitcnt lgkmcnt(0)
    s_barrier
    ds_read_b128 v[32:35], v14 offset:53248
    ds_read_b128 v[36:39], v14 offset:53264
    ds_read_b128 v[40:43], v14 offset:53280
    ds_read_b128 v[44:47], v14 offset:53296
    ds_read_b64 v[48:49], v16 offset:53248
    ds_read_b128 v[64:67], v15 offset:57344
    ds_read_b128 v[68:71], v15 offset:57472
    ds_read_b128 v[72:75], v15 offset:57600
    ds_read_b128 v[76:79], v15 offset:57728
    ds_read_b128 v[80:83], v15 offset:59456
    ds_read_b128 v[84:87], v15 offset:59584
    ds_read_b128 v[88:91], v15 offset:59712
    ds_read_b128 v[92:95], v15 offset:59840
    s_waitcnt lgkmcnt(9)
    v_max3_f32 v32, v32, v33, v34
    v_max3_f32 v35, v35, v36, v37
    v_max3_f32 v38, v38, v39, v40
    v_max3_f32 v41, v41, v42, v43
    v_max3_f32 v44, v44, v45, v46
    v_max3_f32 v32, v32, v35, v38
    v_max3_f32 v41, v41, v44, v47
    v_max_f32 v32, v32, v41
    v_and_b32 v32, s66, v32
    s_waitcnt lgkmcnt(8)
    v_sub_f32 v48, v48, v32
    v_sub_f32 v49, v49, v32
    v_exp_f32 v48, v48
    v_exp_f32 v49, v49
    s_waitcnt lgkmcnt(4)
    v_pk_mul_f32 v[64:65], v[64:65], v[48:49] op_sel:[0,0] op_sel_hi:[1,0]
    v_pk_mul_f32 v[66:67], v[66:67], v[48:49] op_sel:[0,0] op_sel_hi:[1,0]
    v_pk_mul_f32 v[68:69], v[68:69], v[48:49] op_sel:[0,0] op_sel_hi:[1,0]
    v_pk_mul_f32 v[70:71], v[70:71], v[48:49] op_sel:[0,0] op_sel_hi:[1,0]
    v_pk_mul_f32 v[72:73], v[72:73], v[48:49] op_sel:[0,0] op_sel_hi:[1,0]
    v_pk_mul_f32 v[74:75], v[74:75], v[48:49] op_sel:[0,0] op_sel_hi:[1,0]
    v_pk_mul_f32 v[76:77], v[76:77], v[48:49] op_sel:[0,0] op_sel_hi:[1,0]
    v_pk_mul_f32 v[78:79], v[78:79], v[48:49] op_sel:[0,0] op_sel_hi:[1,0]
    s_waitcnt lgkmcnt(0)
    v_pk_fma_f32 v[64:65], v[80:81], v[48:49], v[64:65] op_sel:[0,1,0] op_sel_hi:[1,1,1]
    v_pk_fma_f32 v[66:67], v[82:83], v[48:49], v[66:67] op_sel:[0,1,0] op_sel_hi:[1,1,1]
    v_pk_fma_f32 v[68:69], v[84:85], v[48:49], v[68:69] op_sel:[0,1,0] op_sel_hi:[1,1,1]
    v_pk_fma_f32 v[70:71], v[86:87], v[48:49], v[70:71] op_sel:[0,1,0] op_sel_hi:[1,1,1]
    v_pk_fma_f32 v[72:73], v[88:89], v[48:49], v[72:73] op_sel:[0,1,0] op_sel_hi:[1,1,1]
    v_pk_fma_f32 v[74:75], v[90:91], v[48:49], v[74:75] op_sel:[0,1,0] op_sel_hi:[1,1,1]
    v_pk_fma_f32 v[76:77], v[92:93], v[48:49], v[76:77] op_sel:[0,1,0] op_sel_hi:[1,1,1]
    v_pk_fma_f32 v[78:79], v[94:95], v[48:49], v[78:79] op_sel:[0,1,0] op_sel_hi:[1,1,1]
    s_nop 0
    v_permlane32_swap_b32 v64, v72
    v_permlane32_swap_b32 v65, v73
    v_permlane32_swap_b32 v66, v74
    v_permlane32_swap_b32 v67, v75
    v_permlane32_swap_b32 v68, v76
    v_permlane32_swap_b32 v69, v77
    v_permlane32_swap_b32 v70, v78
    v_permlane32_swap_b32 v71, v79
    v_pk_add_f32 v[64:65], v[64:65], v[72:73]
    v_pk_add_f32 v[66:67], v[66:67], v[74:75]
    v_pk_add_f32 v[68:69], v[68:69], v[76:77]
    v_pk_add_f32 v[70:71], v[70:71], v[78:79]
    s_nop 0
    v_permlane16_swap_b32 v64, v68
    v_permlane16_swap_b32 v65, v69
    v_permlane16_swap_b32 v66, v70
    v_permlane16_swap_b32 v67, v71
    v_pk_add_f32 v[64:65], v[64:65], v[68:69]
    v_pk_add_f32 v[66:67], v[66:67], v[70:71]
    s_nop 1
    v_add_f32_dpp v64, v64, v64 row_ror:8 row_mask:0xf bank_mask:0xf
    v_add_f32_dpp v65, v65, v65 row_ror:8 row_mask:0xf bank_mask:0xf
    v_add_f32_dpp v66, v66, v66 row_ror:8 row_mask:0xf bank_mask:0xf
    v_add_f32_dpp v67, v67, v67 row_ror:8 row_mask:0xf bank_mask:0xf
    s_mov_b32 exec_lo, 0x00ff00ff
    s_mov_b32 exec_hi, 0x00ff00ff
    v_bfi_b32 v64, v9, s60, v64
    v_bfi_b32 v65, v9, s61, v65
    v_bfi_b32 v66, v9, s64, v66
    v_bfi_b32 v67, v9, s65, v67
    buffer_store_dwordx4 v[64:67], v21, s[48:51], s36 offen
    s_mov_b64 s[68:69], exec
    s_mov_b64 exec, -1
L_mir:
    s_add_u32 s36, s36, 3145728
    s_barrier
    s_mov_b64 exec, s[68:69]
    buffer_store_dwordx4 v[64:67], v21, s[48:51], s36 offen sc0 sc1
    s_mov_b64 exec, -1
    s_branch L_hop2
L_stat:
    s_and_b32 s37, s3, 1
    s_lshl_b32 s67, s37, 6
    v_lshlrev_b32 v18, 2, v12
    v_add_u32 v18, s67, v18
    s_lshl_b32 s37, s37, 4
    s_add_u32 s36, s36, s37
    v_mov_b32 v21, 0
    s_waitcnt lgkmcnt(0)
    s_barrier
    ds_read_b32 v50, v18 offset:53248
    ds_read_b32 v51, v18 offset:53376
    s_waitcnt lgkmcnt(1)
    v_max_f32_dpp v32, v50, v50 row_ror:8 row_mask:0xf bank_mask:0xf
    s_nop 1
    v_max_f32_dpp v32, v32, v32 row_ror:4 row_mask:0xf bank_mask:0xf
    s_nop 1
    v_max_f32_dpp v32, v32, v32 row_ror:2 row_mask:0xf bank_mask:0xf
    s_nop 1
    v_max_f32_dpp v32, v32, v32 row_ror:1 row_mask:0xf bank_mask:0xf
    s_nop 1
    v_and_b32 v32, s66, v32
    v_sub_f32 v50, v50, v32
    v_exp_f32 v50, v50
    s_waitcnt lgkmcnt(0)
    v_mul_f32 v33, v50, v51
    s_nop 1
    v_add_f32_dpp v33, v33, v33 row_ror:8 row_mask:0xf bank_mask:0xf
    s_nop 1
    v_add_f32_dpp v33, v33, v33 row_ror:4 row_mask:0xf bank_mask:0xf
    s_nop 1
    v_add_f32_dpp v33, v33, v33 row_ror:2 row_mask:0xf bank_mask:0xf
    s_nop 1
    v_add_f32_dpp v33, v33, v33 row_ror:1 row_mask:0xf bank_mask:0xf
    s_nop 1
    v_bfi_b32 v34, v9, s64, v32
    v_bfi_b32 v35, v9, s65, v33
    v_bfi_b32 v32, v9, s60, v32
    v_bfi_b32 v33, v9, s61, v33
    s_mov_b64 exec, 1
    buffer_store_dwordx4 v[32:35], v21, s[48:51], s36 offen offset:2048
    s_mov_b64 exec, -1
    v_mov_b32 v64, v32
    v_mov_b32 v65, v33
    v_mov_b32 v66, v34
    v_mov_b32 v67, v35
    s_add_u32 s36, s36, 2048
    s_mov_b64 s[68:69], 1
    s_branch L_mir
L_idle:
    s_waitcnt lgkmcnt(0)
    s_barrier
    s_branch L_bar2
L_hop1:
    v_lshrrev_b32 v13, 3, v2
    v_bfe_u32 v14, v2, 1, 2
    v_lshl_add_u32 v13, v14, 3, v13
    v_mov_b32 v15, 17408
    v_mul_lo_u32 v13, v13, v15
    s_mul_i32 s36, s28, 2176
    s_add_u32 s36, s36, 393216
    s_lshl_b32 s37, s29, 6
    s_add_u32 s37, s37, s36
    v_and_b32 v15, 1, v2
    v_lshl_add_u32 v15, v15, 5, v13
    v_add_u32 v15, s37, v15
    s_lshr_b32 s37, s29, 4
    s_lshl_b32 s37, s37, 4
    s_add_u32 s36, s36, s37
    s_add_u32 s36, s36, 2048
    v_add_u32 v13, s36, v13
    v_lshrrev_b32 v19, 1, v11
    v_and_b32 v20, 1, v11
    v_lshl_add_u32 v19, v20, 1, v19
    v_lshlrev_b32 v16, 6, v14
    v_and_b32 v17, 1, v2
    v_lshl_add_u32 v16, v17, 5, v16
    v_lshl_add_u32 v16, v19, 2, v16
    s_mov_b32 s60, 0xffffff00
    v_lshlrev_b32 v18, 2, v2
    v_mov_b32 v20, s33
    v_mov_b32 v21, 0
    s_lshl_b32 s64, s28, 7
    s_add_u32 s64, s64, 1024
    s_lshl_b32 s65, s29, 2
    s_add_u32 s65, s65, s64
    s_lshl_b32 s66, s28, 2
    s_add_u32 s66, s66, 2883584
    s_lshl_b32 s36, s31, 3
    s_lshl_b32 s37, s30, 1
    s_add_u32 s36, s36, s37
    s_lshl_b64 s[98:99], 3, s36
    s_add_u32 s100, s66, 8192
    v_lshlrev_b32 v25, 7, v2
    v_lshrrev_b32 v23, 2, v2
    v_mul_u32_u24 v22, 32, v23
    v_sub_u32 v22, s29, v22
    v_and_b32 v22, 31, v22
    v_and_b32 v24, 3, v2
    v_lshl_add_u32 v22, v24, 5, v22
    v_cmp_gt_u32 vcc, 112, v22
    v_lshlrev_b32 v22, 7, v22
    v_lshl_add_u32 v22, v23, 14, v22
    s_and_b32 s68, vcc_lo, 15
    s_mov_b32 s69, 0
    s_waitcnt lgkmcnt(0)
    s_barrier
    s_mov_b32 exec_lo, -1
    s_mov_b32 exec_hi, 0
    s_mov_b64 exec, -1
    s_mov_b32 s61, 0
    s_mov_b32 s67, 0
    s_branch L_p1
L_p1r:
    s_cmp_lt_u32 s61, 32
    s_cbranch_scc1 L_p1
    s_xor_b32 s67, s67, 3145728
    s_and_b32 s36, s61, 31
    s_cbranch_scc1 L_p1
    buffer_wbl2 sc1
    s_waitcnt vmcnt(0)
L_p1:
    buffer_load_dwordx4 v[32:35], v15, s[48:51], s67 offen sc0 sc1
    buffer_load_dwordx4 v[36:39], v15, s[48:51], s67 offen offset:16 sc0 sc1
    buffer_load_dwordx4 v[40:43], v13, s[48:51], s67 offen sc0 sc1
    s_add_u32 s61, s61, 1
    s_waitcnt vmcnt(0)
    v_perm_b32 v44, v33, v32, s38
    v_perm_b32 v45, v35, v34, s39
    v_or_b32 v44, v44, v45
    v_cmp_ne_u32 s[62:63], s33, v44
    v_perm_b32 v44, v37, v36, s38
    v_perm_b32 v45, v39, v38, s39
    v_or_b32 v44, v44, v45
    v_cmp_ne_u32 vcc, s33, v44
    s_or_b64 s[62:63], s[62:63], vcc
    v_perm_b32 v44, v41, v40, s38
    v_perm_b32 v45, v43, v42, s39
    v_or_b32 v44, v44, v45
    v_cmp_ne_u32 vcc, s33, v44
    s_or_b64 s[62:63], s[62:63], vcc
    s_cmp_gt_u32 s61, 16384
    s_cbranch_scc1 L_p1got
    s_and_b64 exec, exec, s[62:63]
    s_cbranch_scc1 L_p1r
L_p1got:
    s_mov_b64 exec, -1
    s_mov_b64 exec, s[68:69]
    buffer_store_dword v20, v22, s[48:51], s66 offen sc0 sc1
    s_mov_b64 exec, -1
    v_and_b32 v40, s60, v40
    v_mov_b32 v44, v40
    v_mov_b32 v45, v40
    s_nop 1
    v_permlane32_swap_b32 v44, v45
    v_max_f32 v44, v44, v45
    v_mov_b32 v45, v44
    s_nop 1
    v_permlane16_swap_b32 v44, v45
    v_max_f32 v44, v44, v45
    s_nop 1
    v_max_f32_dpp v44, v44, v44 row_ror:8 row_mask:0xf bank_mask:0xf
    v_sub_f32 v40, v40, v44
    v_exp_f32 v40, v40
    s_nop 0
    v_mul_f32 v41, v41, v40
    v_mul_f32 v32, v32, v40
    v_mul_f32 v33, v33, v40
    v_mul_f32 v34, v34, v40
    v_mul_f32 v35, v35, v40
    v_mul_f32 v36, v36, v40
    v_mul_f32 v37, v37, v40
    v_mul_f32 v38, v38, v40
    v_mul_f32 v39, v39, v40
    v_mov_b32 v42, v41
    s_nop 0
    v_permlane32_swap_b32 v32, v33
    v_permlane32_swap_b32 v34, v35
    v_permlane32_swap_b32 v36, v37
    v_permlane32_swap_b32 v38, v39
    v_permlane32_swap_b32 v41, v42
    v_add_f32 v32, v32, v33
    v_add_f32 v34, v34, v35
    v_add_f32 v36, v36, v37
    v_add_f32 v38, v38, v39
    v_add_f32 v41, v41, v42
    v_mov_b32 v42, v41
    s_nop 0
    v_permlane16_swap_b32 v32, v34
    v_permlane16_swap_b32 v36, v38
    v_permlane16_swap_b32 v41, v42
    v_add_f32 v32, v32, v34
    v_add_f32 v36, v36, v38
    v_add_f32 v41, v41, v42
    s_nop 0
    v_add_f32_dpp v32, v32, v32 row_ror:8 row_mask:0xf bank_mask:0xf
    v_add_f32_dpp v36, v36, v36 row_ror:8 row_mask:0xf bank_mask:0xf
    v_add_f32_dpp v41, v41, v41 row_ror:8 row_mask:0xf bank_mask:0xf
    v_rcp_f32 v41, v41
    s_nop 0
    v_mul_f32 v32, v32, v41
    v_mul_f32 v36, v36, v41
    v_cvt_pk_bf16_f32 v32, v32, v32
    v_cvt_pk_bf16_f32 v36, v36, v36
    ds_write_b32 v16, v32 offset:54784
    ds_write_b32 v16, v36 offset:54800
    s_branch L_bar2
L_pre:
    s_waitcnt lgkmcnt(0)
    s_barrier
    s_and_b32 s36, s3, 3
    v_bfe_u32 v15, v2, 3, 1
    v_lshlrev_b32 v16, 6, v15
    v_lshl_add_u32 v16, v11, 4, v16
    v_lshrrev_b32 v17, 1, v11
    v_lshlrev_b32 v18, 2, v17
    ds_read_b32 v22, v18 offset:54336
    ds_read_b32 v23, v18 offset:54344
    s_mul_i32 s60, s2, 7168
    s_add_u32 s60, s60, 1048576
    s_lshl_b32 s61, s36, 9
    s_add_u32 s60, s60, s61
    v_mul_u32_u24 v17, 1792, v17
    v_lshl_add_u32 v17, v12, 5, v17
    v_and_b32 v18, 1, v11
    v_lshl_add_u32 v17, v18, 4, v17
    v_add_u32 v17, s60, v17
    v_mov_b32 v24, 0
    v_mov_b32 v25, 0
    v_mov_b32 v26, 0
    v_mov_b32 v27, 0
    v_mov_b32 v28, 0
    v_mov_b32 v29, 0
    v_mov_b32 v30, 0
    v_mov_b32 v31, 0
    s_sub_u32 s60, s29, 14
    s_cmp_ge_u32 s60, 14
    s_cbranch_scc1 L_noffn
    ds_read_b128 v[96:99], v16 offset:54528
    ds_read_b128 v[100:103], v16 offset:54656
    s_waitcnt lgkmcnt(0)
    v_and_b32 v32, v96, v5
    v_and_b32 v33, v96, v6
    v_and_b32 v34, v96, v7
    v_and_b32 v35, v96, v8
    v_and_b32 v36, v97, v5
    v_and_b32 v37, v97, v6
    v_and_b32 v38, v97, v7
    v_and_b32 v39, v97, v8
    v_and_b32 v40, v98, v5
    v_and_b32 v41, v98, v6
    v_and_b32 v42, v98, v7
    v_and_b32 v43, v98, v8
    v_and_b32 v44, v99, v5
    v_and_b32 v45, v99, v6
    v_and_b32 v46, v99, v7
    v_and_b32 v47, v99, v8
    v_and_b32 v48, v100, v5
    v_and_b32 v49, v100, v6
    v_and_b32 v50, v100, v7
    v_and_b32 v51, v100, v8
    v_and_b32 v52, v101, v5
    v_and_b32 v53, v101, v6
    v_and_b32 v54, v101, v7
    v_and_b32 v55, v101, v8
    v_and_b32 v56, v102, v5
    v_and_b32 v57, v102, v6
    v_and_b32 v58, v102, v7
    v_and_b32 v59, v102, v8
    v_and_b32 v60, v103, v5
    v_and_b32 v61, v103, v6
    v_and_b32 v62, v103, v7
    v_and_b32 v63, v103, v8
    v_sub_f32 v20, 1.0, v22
    v_sub_f32 v21, 1.0, v23
    v_cvt_pk_bf16_f32 v20, 0, v20
    v_cvt_pk_bf16_f32 v21, 0, v21
    s_waitcnt vmcnt(0)
    v_mfma_f32_16x16x32_bf16 v[24:27], v[32:35], v[80:83], 0
    v_mfma_f32_16x16x32_bf16 v[28:31], v[48:51], v[80:83], 0
    v_mfma_f32_16x16x32_bf16 v[24:27], v[36:39], v[84:87], v[24:27]
    v_mfma_f32_16x16x32_bf16 v[28:31], v[52:55], v[84:87], v[28:31]
    v_mfma_f32_16x16x32_bf16 v[24:27], v[40:43], v[88:91], v[24:27]
    v_mfma_f32_16x16x32_bf16 v[28:31], v[56:59], v[88:91], v[28:31]
    v_mfma_f32_16x16x32_bf16 v[24:27], v[44:47], v[92:95], v[24:27]
    v_mfma_f32_16x16x32_bf16 v[28:31], v[60:63], v[92:95], v[28:31]
    s_nop 7
    v_mul_f32 v24, v24, v20
    v_mul_f32 v25, v25, v20
    v_mul_f32 v26, v26, v20
    v_mul_f32 v27, v27, v20
    v_mul_f32 v28, v28, v21
    v_mul_f32 v29, v29, v21
    v_mul_f32 v30, v30, v21
    v_mul_f32 v31, v31, v21
L_noffn:
    s_and_b32 s60, s33, 0xff
    s_bfe_u32 s61, s33, 0x80008
    s_bfe_u32 s64, s33, 0x80010
    s_lshr_b32 s65, s33, 24
    v_mov_b32 v9, 0xff
    s_cmp_eq_u32 s36, 3
    s_cselect_b32 s66, 0x00ff00ff, -1
    s_waitcnt vmcnt(0)
L_bar2:
    s_waitcnt lgkmcnt(0)
    s_barrier
    s_cmp_lt_u32 s3, 12
    s_cbranch_scc1 L_hop2
    ds_read_b128 v[96:99], v16 offset:54784
    ds_read_b128 v[100:103], v16 offset:54912
    s_waitcnt lgkmcnt(1)
    v_and_b32 v32, v96, v5
    v_and_b32 v33, v96, v6
    v_and_b32 v34, v96, v7
    v_and_b32 v35, v96, v8
    v_and_b32 v36, v97, v5
    v_and_b32 v37, v97, v6
    v_and_b32 v38, v97, v7
    v_and_b32 v39, v97, v8
    v_and_b32 v40, v98, v5
    v_and_b32 v41, v98, v6
    v_and_b32 v42, v98, v7
    v_and_b32 v43, v98, v8
    v_and_b32 v44, v99, v5
    v_and_b32 v45, v99, v6
    v_and_b32 v46, v99, v7
    v_and_b32 v47, v99, v8
    s_nop 0
    v_mfma_f32_16x16x32_bf16 v[104:107], v[32:35], v[64:67], 0
    v_mfma_f32_16x16x32_bf16 v[104:107], v[36:39], v[68:71], v[104:107]
    v_mfma_f32_16x16x32_bf16 v[104:107], v[40:43], v[72:75], v[104:107]
    v_mfma_f32_16x16x32_bf16 v[104:107], v[44:47], v[76:79], v[104:107]
    s_waitcnt lgkmcnt(0)
    v_and_b32 v48, v100, v5
    v_and_b32 v49, v100, v6
    v_and_b32 v50, v100, v7
    v_and_b32 v51, v100, v8
    v_and_b32 v52, v101, v5
    v_and_b32 v53, v101, v6
    v_and_b32 v54, v101, v7
    v_and_b32 v55, v101, v8
    v_and_b32 v56, v102, v5
    v_and_b32 v57, v102, v6
    v_and_b32 v58, v102, v7
    v_and_b32 v59, v102, v8
    v_and_b32 v60, v103, v5
    v_and_b32 v61, v103, v6
    v_and_b32 v62, v103, v7
    v_and_b32 v63, v103, v8
    v_mfma_f32_16x16x32_bf16 v[108:111], v[48:51], v[64:67], 0
    v_mfma_f32_16x16x32_bf16 v[108:111], v[52:55], v[68:71], v[108:111]
    v_mfma_f32_16x16x32_bf16 v[108:111], v[56:59], v[72:75], v[108:111]
    v_mfma_f32_16x16x32_bf16 v[108:111], v[60:63], v[76:79], v[108:111]
    v_fmac_f32 v24, v104, v22
    v_fmac_f32 v25, v105, v22
    v_fmac_f32 v26, v106, v22
    v_fmac_f32 v27, v107, v22
    v_bfi_b32 v24, v9, s60, v24
    v_bfi_b32 v25, v9, s61, v25
    v_bfi_b32 v26, v9, s64, v26
    v_bfi_b32 v27, v9, s65, v27
    v_fmac_f32 v28, v108, v23
    v_fmac_f32 v29, v109, v23
    v_fmac_f32 v30, v110, v23
    v_fmac_f32 v31, v111, v23
    v_bfi_b32 v28, v9, s60, v28
    v_bfi_b32 v29, v9, s61, v29
    v_bfi_b32 v30, v9, s64, v30
    v_bfi_b32 v31, v9, s65, v31
    s_mov_b32 exec_lo, s66
    s_mov_b32 exec_hi, s66
    buffer_store_dwordx4 v[24:27], v17, s[48:51], 0 offen sc0 sc1
    buffer_store_dwordx4 v[28:31], v17, s[48:51], 0 offen offset:3584 sc0 sc1
    s_mov_b64 exec, -1
L_hop2:
    s_cmp_ge_u32 s2, 112
    s_cbranch_scc1 L_fin
    s_lshl_b32 s36, s3, 4
    v_lshrrev_b32 v13, 2, v2
    v_add_u32 v13, s36, v13
    v_mul_u32_u24 v13, 7168, v13
    v_and_b32 v14, 3, v2
    v_lshl_add_u32 v13, v14, 4, v13
    s_lshl_b32 s36, s2, 6
    s_add_u32 s36, s36, 1048576
    v_add_u32 v13, s36, v13
    v_lshrrev_b32 v19, 1, v11
    v_and_b32 v20, 1, v11
    v_lshl_add_u32 v19, v20, 1, v19
    v_lshl_add_u32 v15, v14, 2, v19
    v_lshlrev_b32 v15, 6, v15
    s_lshl_b32 s36, s3, 2
    v_add_u32 v15, s36, v15
    s_cmp_lg_u32 s3, 7
    s_cbranch_scc1 L_b2_ok
    v_and_b32 v18, 7, v2
    v_lshlrev_b32 v18, 2, v18
    v_lshrrev_b32 v17, 3, v2
    v_lshl_add_u32 v18, v17, 14, v18
    s_lshl_b32 s64, s2, 7
    s_add_u32 s64, s64, 2883584
    s_mov_b32 exec_lo, 255
    s_mov_b32 exec_hi, 0
    buffer_load_dword v32, v18, s[48:51], s64 offen sc0 sc1
    s_mov_b32 s61, 0
L_b2:
    s_waitcnt vmcnt(0)
    v_cmp_eq_u32 vcc, s33, v32
    s_mov_b32 s36, vcc_lo
    s_and_b32 s36, s36, 0xff
    s_cmp_eq_u32 s36, 0xff
    s_cbranch_scc1 L_b2_ok
    buffer_load_dword v32, v18, s[48:51], s64 offen sc0 sc1
    s_add_u32 s61, s61, 1
    s_cmp_lt_u32 s61, 16384
    s_cbranch_scc1 L_b2
L_b2_ok:
    s_mov_b64 exec, -1
    s_barrier
    s_mov_b32 s61, 0
    s_branch L_p2
L_p2r:
L_p2:
    buffer_load_dwordx4 v[32:35], v13, s[48:51], 0 offen sc0 sc1
    s_add_u32 s61, s61, 1
    s_waitcnt vmcnt(0)
    v_perm_b32 v44, v33, v32, s38
    v_perm_b32 v45, v35, v34, s39
    v_or_b32 v44, v44, v45
    v_cmp_ne_u32 s[62:63], s33, v44
    s_cmp_gt_u32 s61, 16384
    s_cbranch_scc1 L_p2got
    s_and_b64 exec, exec, s[62:63]
    s_cbranch_scc1 L_p2r
L_p2got:
    s_mov_b64 exec, -1
    v_permlane32_swap_b32 v32, v33
    v_permlane32_swap_b32 v34, v35
    v_add_f32 v32, v32, v33
    v_add_f32 v34, v34, v35
    s_nop 1
    v_permlane16_swap_b32 v32, v34
    v_add_f32 v32, v32, v34
    s_nop 1
    v_add_f32_dpp v32, v32, v32 row_ror:4 row_mask:0xf bank_mask:0xf
    s_nop 1
    v_add_f32_dpp v32, v32, v32 row_ror:8 row_mask:0xf bank_mask:0xf
    s_mov_b32 exec_lo, 0x000f000f
    s_mov_b32 exec_hi, 0x000f000f
    ds_write_b32 v15, v32 offset:0
    s_mov_b64 exec, -1
    s_waitcnt lgkmcnt(0)
    s_barrier
    s_cmp_lg_u32 s3, 0
    s_cbranch_scc1 L_fin
    v_lshlrev_b32 v13, 6, v12
    v_lshl_add_u32 v13, v11, 4, v13
    ds_read_b128 v[32:35], v13 offset:0
    s_mov_b32 s52, s22
    s_and_b32 s53, s23, 0xffff
    s_mov_b32 s54, 3584
    s_mov_b32 s55, 0x20000
    s_lshl_b32 s36, s2, 5
    v_lshlrev_b32 v14, 1, v12
    v_add_u32 v14, s36, v14
    s_waitcnt lgkmcnt(0)
    v_add_f32 v32, v32, v33
    v_add_f32 v34, v34, v35
    v_add_f32 v32, v32, v34
    v_mov_b32 v33, v32
    s_nop 1
    v_permlane32_swap_b32 v32, v33
    v_add_f32 v32, v32, v33
    v_mov_b32 v33, v32
    s_nop 1
    v_permlane16_swap_b32 v32, v33
    v_add_f32 v32, v32, v33
    v_cvt_pk_bf16_f32 v32, v32, v32
    s_mov_b64 exec, 0xffff
    buffer_store_short v32, v14, s[52:55], 0 offen
    s_mov_b64 exec, -1
    s_cmp_lg_u32 s2, 0
    s_cbranch_scc1 L_fin
    v_mov_b32 v13, 0
    v_mov_b32 v14, s33
    s_mov_b64 exec, 1
    buffer_store_dword v14, v13, s[48:51], 0 offen
    s_mov_b64 exec, -1
L_fin:
L_end:
    s_endpgm
.section .rodata,"a"
.p2align 6
.amdhsa_kernel gated_mix__sliding_block_cached__dense_activation_relu__decode_kernel
  .amdhsa_next_free_vgpr 128
  .amdhsa_next_free_sgpr 102
  .amdhsa_accum_offset 128
  .amdhsa_group_segment_fixed_size 0
  .amdhsa_kernarg_size 96
  .amdhsa_user_sgpr_count 2
  .amdhsa_user_sgpr_kernarg_segment_ptr 1
  .amdhsa_system_sgpr_workgroup_id_x 1
.end_amdhsa_kernel
```
